```python
import torch

def _softmax(x, axis=-1):
    return torch.softmax(x, dim=axis)
def _gelu(x):
    return torch.nn.functional.gelu(x, approximate="tanh")
def _silu(x):
    return torch.nn.functional.silu(x)
def _sigmoid(x):
    return torch.sigmoid(x)
def _layernorm(x, axis=-1, eps=1e-5):
    m = x.mean(dim=axis, keepdim=True)
    v = x.var(dim=axis, keepdim=True, unbiased=False)
    return (x - m) / torch.sqrt(v + eps)
def _scatter_add(tgt, idx, src, axis=0):
    return tgt.clone().index_add_(axis, idx, src)
def _segment_sum(src, seg, n):
    out = torch.zeros((n,) + src.shape[1:], dtype=src.dtype)
    return out.index_add_(0, seg, src)
def _pad(x, pw):
    flat = tuple(v for pair in reversed(pw) for v in pair)
    return torch.nn.functional.pad(x, flat)

kernel_name = 'standalone__mha_softmax__sampling'

def setup_inputs():

    _w = (lambda a: (lambda t: t.to(torch.bfloat16) if t.is_floating_point() else t)(torch.as_tensor(a)))
    B, H, Sq, Sk, D = 8, 32, 8, 4096, 128
    return {
        "q": _w((lambda *s: torch.randn(*s, dtype=torch.bfloat16) * 0.8)(B, H, Sq, D)),
        "k": _w((lambda *s: torch.randn(*s, dtype=torch.bfloat16) * 0.8)(B, H, Sk, D)),
        "v": _w((lambda *s: torch.randn(*s, dtype=torch.bfloat16) * 0.05)(B, H, Sk, D)),
    }

def reference(q, k, v):
    scale = q.shape[-1] ** -0.5
    scores = torch.einsum("bhqd,bhkd->bhqk", q, k) * scale
    p = _softmax(scores, axis=-1)
    return torch.einsum("bhqk,bhkd->bhqd", p, v)
```

```asm
; @launch grid=(256,1,1) block=(128,1,1) lds=134144
.amdgcn_target "amdgcn-amd-amdhsa--gfx950"
.text
.globl standalone__mha_softmax__sampling_kernel
.p2align 12
.p2align 8
.type standalone__mha_softmax__sampling_kernel,@function
standalone__mha_softmax__sampling_kernel:
    s_cmp_ge_u32 s2, 256
    s_cbranch_scc1 L_end
    v_readfirstlane_b32 s54, v0
    s_load_dwordx8 s[4:11], s[0:1], 0
    s_load_dwordx2 s[56:57], s[0:1], 32
    v_and_b32 v0, 63, v0
    v_and_b32 v3, 1, v0
    v_lshlrev_b32 v124, 4, v3
    v_lshrrev_b32 v4, 4, v0
    v_lshl_add_u32 v124, v4, 5, v124
    v_bfe_i32 v3, v0, 2, 1
    v_and_b32 v3, 0x800, v3
    v_xor_b32 v124, v124, v3
    v_bfe_i32 v3, v0, 3, 1
    v_and_b32 v3, 0x2000, v3
    v_xor_b32 v124, v124, v3
    v_bfe_i32 v3, v0, 1, 1
    v_and_b32 v3, 0x4000, v3
    v_xor_b32 v124, v124, v3
    v_xor_b32 v120, 0x0, v124
    v_xor_b32 v121, 0x8000, v124
    v_xor_b32 v122, 0x1000, v124
    v_xor_b32 v123, 0x9000, v124
    v_and_b32 v3, 7, v0
    v_lshlrev_b32 v3, 8, v3
    v_lshl_add_u32 v3, v4, 5, v3
    v_bfe_u32 v4, v0, 3, 1
    v_lshl_add_u32 v20, v4, 4, v3
    s_lshl_b32 s37, s2, 20
    s_lshl_b32 s35, s2, 11
    s_mov_b32 s15, 0x20000
    s_mov_b32 s19, 0x20000
    s_mov_b32 s27, 0x20000
    s_mov_b32 s31, 0x20000
    s_mov_b32 s59, 0x20000
    s_cmp_lt_u32 s54, 64
    s_cselect_b32 s14, 0x100000, 0
    s_cselect_b32 s18, 0x100000, 0
    s_cselect_b32 s26, 0x800, 0
    s_cselect_b32 s30, 0x800, 0
    s_cselect_b32 s58, 0x20, 0
    s_mov_b32 s21, 0
    s_mov_b32 s52, 0
    s_mov_b32 s20, 0
    v_mov_b32 v23, 0xff800000
    v_mov_b32 v2, v23
    s_waitcnt lgkmcnt(0)
    s_add_u32 s12, s6, s37
    s_addc_u32 s13, s7, 0
    s_add_u32 s24, s4, s35
    s_addc_u32 s25, s5, 0
    s_add_u32 s16, s8, s37
    s_addc_u32 s17, s9, 0
    s_add_u32 s28, s10, s35
    s_addc_u32 s29, s11, 0
    s_cmp_lt_u32 s54, 64
    s_cbranch_scc0 L_init
    buffer_load_dwordx4 v[96:99], v20, s[24:27], 0 offen offset:0
    buffer_load_dwordx4 v[100:103], v20, s[24:27], 0 offen offset:128
    buffer_load_dwordx4 a[0:3], v120, s[12:15], s20 offen offset:0 nt
    buffer_load_dwordx4 a[4:7], v120, s[12:15], s20 offen offset:128 nt
    buffer_load_dwordx4 a[8:11], v121, s[12:15], s20 offen offset:256 nt
    buffer_load_dwordx4 a[12:15], v121, s[12:15], s20 offen offset:384 nt
    buffer_load_dwordx4 a[16:19], v122, s[12:15], s20 offen offset:0 nt
    buffer_load_dwordx4 a[20:23], v122, s[12:15], s20 offen offset:128 nt
    buffer_load_dwordx4 a[24:27], v123, s[12:15], s20 offen offset:256 nt
    buffer_load_dwordx4 a[28:31], v123, s[12:15], s20 offen offset:384 nt
    buffer_load_dwordx4 a[32:35], v120, s[12:15], s20 offen offset:256 nt
    buffer_load_dwordx4 a[36:39], v120, s[12:15], s20 offen offset:384 nt
    buffer_load_dwordx4 a[40:43], v121, s[12:15], s20 offen offset:0 nt
    buffer_load_dwordx4 a[44:47], v121, s[12:15], s20 offen offset:128 nt
    buffer_load_dwordx4 a[48:51], v122, s[12:15], s20 offen offset:256 nt
    buffer_load_dwordx4 a[52:55], v122, s[12:15], s20 offen offset:384 nt
    buffer_load_dwordx4 a[56:59], v123, s[12:15], s20 offen offset:0 nt
    buffer_load_dwordx4 a[60:63], v123, s[12:15], s20 offen offset:128 nt
    buffer_load_dwordx4 a[64:67], v120, s[12:15], s20 offen offset:1024 nt
    buffer_load_dwordx4 a[68:71], v120, s[12:15], s20 offen offset:1152 nt
    buffer_load_dwordx4 a[72:75], v121, s[12:15], s20 offen offset:1280 nt
    buffer_load_dwordx4 a[76:79], v121, s[12:15], s20 offen offset:1408 nt
    buffer_load_dwordx4 a[80:83], v122, s[12:15], s20 offen offset:1024 nt
    buffer_load_dwordx4 a[84:87], v122, s[12:15], s20 offen offset:1152 nt
    buffer_load_dwordx4 a[88:91], v123, s[12:15], s20 offen offset:1280 nt
    buffer_load_dwordx4 a[92:95], v123, s[12:15], s20 offen offset:1408 nt
    buffer_load_dwordx4 a[96:99], v120, s[12:15], s20 offen offset:1280 nt
    buffer_load_dwordx4 a[100:103], v120, s[12:15], s20 offen offset:1408 nt
    s_mov_b32 s52, 1
    s_mov_b32 s21, 0x200
    buffer_load_dwordx4 a[104:107], v121, s[12:15], s20 offen offset:1024 nt
    buffer_load_dwordx4 a[108:111], v121, s[12:15], s20 offen offset:1152 nt
    buffer_load_dwordx4 a[112:115], v122, s[12:15], s20 offen offset:1280 nt
    buffer_load_dwordx4 a[116:119], v122, s[12:15], s20 offen offset:1408 nt
L_init:
    v_mov_b32 v11, 0
    v_bfe_i32 v3, v0, 0, 1
    v_and_b32 v3, 0x200, v3
    v_xor_b32 v11, v11, v3
    v_bfe_i32 v3, v0, 1, 1
    v_and_b32 v3, 0x20000, v3
    v_xor_b32 v11, v11, v3
    v_bfe_i32 v3, v0, 2, 1
    v_and_b32 v3, 0x40000, v3
    v_xor_b32 v11, v11, v3
    v_bfe_i32 v3, v0, 3, 1
    v_and_b32 v3, 0x80000, v3
    v_xor_b32 v11, v11, v3
    v_bfe_i32 v3, v0, 4, 1
    v_and_b32 v3, 0x10000, v3
    v_xor_b32 v11, v11, v3
    v_bfe_i32 v3, v0, 5, 1
    v_and_b32 v3, 0x100000, v3
    v_xor_b32 v11, v11, v3
    v_lshlrev_b32 v1, 4, v0
    v_mov_b32 v28, v23
    v_mov_b32 v116, v23
    v_mov_b32 v29, v23
    v_mov_b32 v117, v23
    v_mov_b32 v30, v23
    v_mov_b32 v118, v23
    v_mov_b32 v31, v23
    v_mov_b32 v119, v23
    s_mov_b32 s33, 31
    s_mov_b32 s39, 16
    s_mov_b32 s60, -1
    s_mov_b32 s62, 0
    s_lshr_b32 s55, s2, 3
    v_lshlrev_b32 v9, 8, v0
    v_add_u32 v9, s55, v9
    v_mov_b32 v5, 0
    v_mov_b32 v6, 0
    v_and_b32 v3, 15, v0
    v_lshlrev_b32 v125, 4, v3
    v_bfe_i32 v3, v0, 4, 1
    v_and_b32 v3, 0x800, v3
    v_xor_b32 v125, v125, v3
    v_bfe_i32 v3, v0, 5, 1
    v_and_b32 v3, 0x2000, v3
    v_xor_b32 v125, v125, v3
    v_xor_b32 v12, 0x0, v125
    v_xor_b32 v13, 0x4000, v125
    v_xor_b32 v14, 0x8000, v125
    v_xor_b32 v15, 0xc000, v125
    v_xor_b32 v16, 0x1000, v125
    v_xor_b32 v17, 0x5000, v125
    v_xor_b32 v18, 0x9000, v125
    v_xor_b32 v19, 0xd000, v125
    s_mov_b32 s22, 0x3e0293ee
    s_mov_b32 s34, 0x05040100
    s_mov_b32 s32, 0x07060302
    v_mov_b32 v3, 0x3f803f80
    v_accvgpr_write_b32 a128, 0
    v_accvgpr_write_b32 a132, v3
    v_accvgpr_write_b32 a129, 0
    v_accvgpr_write_b32 a133, v3
    v_accvgpr_write_b32 a130, 0
    v_accvgpr_write_b32 a134, v3
    v_accvgpr_write_b32 a131, 0
    v_accvgpr_write_b32 a135, v3
    v_mov_b64 v[32:33], 0
    v_mov_b64 v[34:35], 0
    v_mov_b64 v[36:37], 0
    v_mov_b64 v[38:39], 0
    v_mov_b64 v[40:41], 0
    v_mov_b64 v[42:43], 0
    v_mov_b64 v[44:45], 0
    v_mov_b64 v[46:47], 0
    v_mov_b64 v[48:49], 0
    v_mov_b64 v[50:51], 0
    v_mov_b64 v[52:53], 0
    v_mov_b64 v[54:55], 0
    v_mov_b64 v[56:57], 0
    v_mov_b64 v[58:59], 0
    v_mov_b64 v[60:61], 0
    v_mov_b64 v[62:63], 0
    v_mov_b64 v[64:65], 0
    v_mov_b64 v[66:67], 0
    v_mov_b64 v[68:69], 0
    v_mov_b64 v[70:71], 0
    v_mov_b64 v[72:73], 0
    v_mov_b64 v[74:75], 0
    v_mov_b64 v[76:77], 0
    v_mov_b64 v[78:79], 0
    v_mov_b64 v[80:81], 0
    v_mov_b64 v[82:83], 0
    v_mov_b64 v[84:85], 0
    v_mov_b64 v[86:87], 0
    v_mov_b64 v[88:89], 0
    v_mov_b64 v[90:91], 0
    v_mov_b64 v[92:93], 0
    v_mov_b64 v[94:95], 0
    s_cmp_lt_u32 s54, 64
    s_cbranch_scc1 L_go
    s_mov_b64 exec, 0
    s_mov_b32 s33, 1
    s_branch L_mid
L_go:
L_k:
    s_waitcnt vmcnt(24)
    s_cmp_gt_i32 s39, 2
    s_cbranch_scc1 L_w1
    s_waitcnt vmcnt(21)
L_w1:
    s_add_u32 s62, s62, 1
    v_mov_b32 v8, s62
    buffer_store_byte v8, v9, s[56:59], 0 offen
    buffer_load_ubyte v5, v0, s[56:59], 0 offen sc0
    buffer_load_dwordx4 a[120:123], v123, s[12:15], s20 offen offset:1024 nt
    buffer_load_dwordx4 a[124:127], v123, s[12:15], s20 offen offset:1152 nt
    s_mov_b32 s20, s21
    v_mfma_f32_16x16x32_bf16 v[104:107], a[0:3], v[96:99], 0
    v_mfma_f32_16x16x32_bf16 v[104:107], a[4:7], v[100:103], v[104:107]
    v_add_f32_dpp v30, v116, v117 row_ror:8 row_mask:0xf bank_mask:0xc
    v_add_f32_dpp v31, v118, v119 row_ror:8 row_mask:0xf bank_mask:0xc
    ds_write_b128 v1, v[28:31] offset:0
    v_max3_f32 v2, v28, v29, v2
    v_max3_f32 v2, v30, v31, v2
    s_waitcnt vmcnt(24)
    s_cmp_gt_i32 s39, 18
    s_cbranch_scc1 L_w2
    s_waitcnt vmcnt(21)
L_w2:
    buffer_load_dwordx4 a[0:3], v120, s[12:15], s20 offen offset:0 nt
    buffer_load_dwordx4 a[4:7], v120, s[12:15], s20 offen offset:128 nt
    v_mfma_f32_16x16x32_bf16 v[108:111], a[8:11], v[96:99], 0
    v_mfma_f32_16x16x32_bf16 v[108:111], a[12:15], v[100:103], v[108:111]
    v_add_f32_dpp v24, v105, v104 row_ror:8 row_mask:0xf bank_mask:0x3
    v_add_f32_dpp v25, v107, v106 row_ror:8 row_mask:0xf bank_mask:0x3
    s_waitcnt vmcnt(24)
    s_cmp_gt_i32 s39, 10
    s_cbranch_scc1 L_w3
    s_waitcnt vmcnt(21)
L_w3:
    buffer_load_dwordx4 a[8:11], v121, s[12:15], s20 offen offset:256 nt
    buffer_load_dwordx4 a[12:15], v121, s[12:15], s20 offen offset:384 nt
    v_mfma_f32_16x16x32_bf16 v[112:115], a[16:19], v[96:99], 0
    v_mfma_f32_16x16x32_bf16 v[112:115], a[20:23], v[100:103], v[112:115]
    v_add_f32_dpp v26, v109, v108 row_ror:8 row_mask:0xf bank_mask:0x3
    v_add_f32_dpp v27, v111, v110 row_ror:8 row_mask:0xf bank_mask:0x3
    s_waitcnt vmcnt(24)
    s_cmp_gt_i32 s39, 26
    s_cbranch_scc1 L_w4
    s_waitcnt vmcnt(21)
L_w4:
    buffer_load_dwordx4 a[16:19], v122, s[12:15], s20 offen offset:0 nt
    buffer_load_dwordx4 a[20:23], v122, s[12:15], s20 offen offset:128 nt
    v_mfma_f32_16x16x32_bf16 v[116:119], a[24:27], v[96:99], 0
    v_mfma_f32_16x16x32_bf16 v[116:119], a[28:31], v[100:103], v[116:119]
    v_add_f32_dpp v28, v113, v112 row_ror:8 row_mask:0xf bank_mask:0x3
    v_add_f32_dpp v29, v115, v114 row_ror:8 row_mask:0xf bank_mask:0x3
    s_waitcnt vmcnt(24)
    s_cmp_gt_i32 s39, 6
    s_cbranch_scc1 L_w5
    s_waitcnt vmcnt(21)
L_w5:
    v_cmp_lt_i32 vcc, s60, v6
    s_bcnt1_i32_b32 s39, vcc_lo
    s_cmp_lt_i32 s60, 4
    s_cselect_b32 s39, 16, s39
    s_add_u32 s60, s60, 1
    buffer_load_dwordx4 a[24:27], v123, s[12:15], s20 offen offset:256 nt
    buffer_load_dwordx4 a[28:31], v123, s[12:15], s20 offen offset:384 nt
    v_mfma_f32_16x16x32_bf16 v[104:107], a[32:35], v[96:99], 0
    v_mfma_f32_16x16x32_bf16 v[104:107], a[36:39], v[100:103], v[104:107]
    v_add_f32_dpp v30, v117, v116 row_ror:8 row_mask:0xf bank_mask:0x3
    v_add_f32_dpp v31, v119, v118 row_ror:8 row_mask:0xf bank_mask:0x3
    s_waitcnt vmcnt(24)
    s_cmp_gt_i32 s39, 22
    s_cbranch_scc1 L_w6
    s_waitcnt vmcnt(21)
L_w6:
    buffer_load_dwordx4 a[32:35], v120, s[12:15], s20 offen offset:256 nt
    buffer_load_dwordx4 a[36:39], v120, s[12:15], s20 offen offset:384 nt
    v_mfma_f32_16x16x32_bf16 v[108:111], a[40:43], v[96:99], 0
    v_mfma_f32_16x16x32_bf16 v[108:111], a[44:47], v[100:103], v[108:111]
    v_add_f32_dpp v24, v104, v105 row_ror:8 row_mask:0xf bank_mask:0xc
    v_add_f32_dpp v25, v106, v107 row_ror:8 row_mask:0xf bank_mask:0xc
    s_waitcnt vmcnt(24)
    s_cmp_gt_i32 s39, 14
    s_cbranch_scc1 L_w7
    s_waitcnt vmcnt(21)
L_w7:
    buffer_load_dwordx4 a[40:43], v121, s[12:15], s20 offen offset:0 nt
    buffer_load_dwordx4 a[44:47], v121, s[12:15], s20 offen offset:128 nt
    v_mfma_f32_16x16x32_bf16 v[112:115], a[48:51], v[96:99], 0
    v_mfma_f32_16x16x32_bf16 v[112:115], a[52:55], v[100:103], v[112:115]
    v_add_f32_dpp v26, v108, v109 row_ror:8 row_mask:0xf bank_mask:0xc
    v_add_f32_dpp v27, v110, v111 row_ror:8 row_mask:0xf bank_mask:0xc
    ds_write_b128 v1, v[24:27] offset:1024
    v_max3_f32 v2, v24, v25, v2
    v_max3_f32 v2, v26, v27, v2
    s_waitcnt vmcnt(24)
    s_cmp_gt_i32 s39, 30
    s_cbranch_scc1 L_w8
    s_waitcnt vmcnt(21)
L_w8:
    buffer_load_dwordx4 a[48:51], v122, s[12:15], s20 offen offset:256 nt
    buffer_load_dwordx4 a[52:55], v122, s[12:15], s20 offen offset:384 nt
    v_mfma_f32_16x16x32_bf16 v[116:119], a[56:59], v[96:99], 0
    v_mfma_f32_16x16x32_bf16 v[116:119], a[60:63], v[100:103], v[116:119]
    v_add_f32_dpp v28, v112, v113 row_ror:8 row_mask:0xf bank_mask:0xc
    v_add_f32_dpp v29, v114, v115 row_ror:8 row_mask:0xf bank_mask:0xc
    s_waitcnt vmcnt(24)
    s_cmp_gt_i32 s39, 2
    s_cbranch_scc1 L_w9
    s_waitcnt vmcnt(21)
L_w9:
    s_add_u32 s62, s62, 1
    v_mov_b32 v8, s62
    buffer_store_byte v8, v9, s[56:59], 0 offen
    buffer_load_ubyte v6, v0, s[56:59], 0 offen sc0
    buffer_load_dwordx4 a[56:59], v123, s[12:15], s20 offen offset:0 nt
    buffer_load_dwordx4 a[60:63], v123, s[12:15], s20 offen offset:128 nt
    v_mfma_f32_16x16x32_bf16 v[104:107], a[64:67], v[96:99], 0
    v_mfma_f32_16x16x32_bf16 v[104:107], a[68:71], v[100:103], v[104:107]
    v_add_f32_dpp v30, v116, v117 row_ror:8 row_mask:0xf bank_mask:0xc
    v_add_f32_dpp v31, v118, v119 row_ror:8 row_mask:0xf bank_mask:0xc
    ds_write_b128 v1, v[28:31] offset:2048
    v_max3_f32 v2, v28, v29, v2
    v_max3_f32 v2, v30, v31, v2
    s_waitcnt vmcnt(24)
    s_cmp_gt_i32 s39, 18
    s_cbranch_scc1 L_w10
    s_waitcnt vmcnt(21)
L_w10:
    buffer_load_dwordx4 a[64:67], v120, s[12:15], s20 offen offset:1024 nt
    buffer_load_dwordx4 a[68:71], v120, s[12:15], s20 offen offset:1152 nt
    v_mfma_f32_16x16x32_bf16 v[108:111], a[72:75], v[96:99], 0
    v_mfma_f32_16x16x32_bf16 v[108:111], a[76:79], v[100:103], v[108:111]
    v_add_f32_dpp v24, v105, v104 row_ror:8 row_mask:0xf bank_mask:0x3
    v_add_f32_dpp v25, v107, v106 row_ror:8 row_mask:0xf bank_mask:0x3
    s_waitcnt vmcnt(24)
    s_cmp_gt_i32 s39, 10
    s_cbranch_scc1 L_w11
    s_waitcnt vmcnt(21)
L_w11:
    buffer_load_dwordx4 a[72:75], v121, s[12:15], s20 offen offset:1280 nt
    buffer_load_dwordx4 a[76:79], v121, s[12:15], s20 offen offset:1408 nt
    v_mfma_f32_16x16x32_bf16 v[112:115], a[80:83], v[96:99], 0
    v_mfma_f32_16x16x32_bf16 v[112:115], a[84:87], v[100:103], v[112:115]
    v_add_f32_dpp v26, v109, v108 row_ror:8 row_mask:0xf bank_mask:0x3
    v_add_f32_dpp v27, v111, v110 row_ror:8 row_mask:0xf bank_mask:0x3
    s_waitcnt vmcnt(24)
    s_cmp_gt_i32 s39, 26
    s_cbranch_scc1 L_w12
    s_waitcnt vmcnt(21)
L_w12:
    buffer_load_dwordx4 a[80:83], v122, s[12:15], s20 offen offset:1024 nt
    buffer_load_dwordx4 a[84:87], v122, s[12:15], s20 offen offset:1152 nt
    v_mfma_f32_16x16x32_bf16 v[116:119], a[88:91], v[96:99], 0
    v_mfma_f32_16x16x32_bf16 v[116:119], a[92:95], v[100:103], v[116:119]
    v_add_f32_dpp v28, v113, v112 row_ror:8 row_mask:0xf bank_mask:0x3
    v_add_f32_dpp v29, v115, v114 row_ror:8 row_mask:0xf bank_mask:0x3
    s_waitcnt vmcnt(24)
    s_cmp_gt_i32 s39, 6
    s_cbranch_scc1 L_w13
    s_waitcnt vmcnt(21)
L_w13:
    v_cmp_lt_i32 vcc, s60, v5
    s_bcnt1_i32_b32 s39, vcc_lo
    s_cmp_lt_i32 s60, 4
    s_cselect_b32 s39, 16, s39
    s_add_u32 s60, s60, 1
    buffer_load_dwordx4 a[88:91], v123, s[12:15], s20 offen offset:1280 nt
    buffer_load_dwordx4 a[92:95], v123, s[12:15], s20 offen offset:1408 nt
    v_mfma_f32_16x16x32_bf16 v[104:107], a[96:99], v[96:99], 0
    v_mfma_f32_16x16x32_bf16 v[104:107], a[100:103], v[100:103], v[104:107]
    v_add_f32_dpp v30, v117, v116 row_ror:8 row_mask:0xf bank_mask:0x3
    v_add_f32_dpp v31, v119, v118 row_ror:8 row_mask:0xf bank_mask:0x3
    s_waitcnt vmcnt(24)
    s_cmp_gt_i32 s39, 22
    s_cbranch_scc1 L_w14
    s_waitcnt vmcnt(21)
L_w14:
    buffer_load_dwordx4 a[96:99], v120, s[12:15], s20 offen offset:1280 nt
    buffer_load_dwordx4 a[100:103], v120, s[12:15], s20 offen offset:1408 nt
    s_add_u32 s52, s52, 1
    v_readlane_b32 s21, v11, s52
    v_mfma_f32_16x16x32_bf16 v[108:111], a[104:107], v[96:99], 0
    v_mfma_f32_16x16x32_bf16 v[108:111], a[108:111], v[100:103], v[108:111]
    v_add_f32_dpp v24, v104, v105 row_ror:8 row_mask:0xf bank_mask:0xc
    v_add_f32_dpp v25, v106, v107 row_ror:8 row_mask:0xf bank_mask:0xc
    s_waitcnt vmcnt(24)
    s_cmp_gt_i32 s39, 14
    s_cbranch_scc1 L_w15
    s_waitcnt vmcnt(21)
L_w15:
    buffer_load_dwordx4 a[104:107], v121, s[12:15], s20 offen offset:1024 nt
    buffer_load_dwordx4 a[108:111], v121, s[12:15], s20 offen offset:1152 nt
    v_mfma_f32_16x16x32_bf16 v[112:115], a[112:115], v[96:99], 0
    v_mfma_f32_16x16x32_bf16 v[112:115], a[116:119], v[100:103], v[112:115]
    v_add_f32_dpp v26, v108, v109 row_ror:8 row_mask:0xf bank_mask:0xc
    v_add_f32_dpp v27, v110, v111 row_ror:8 row_mask:0xf bank_mask:0xc
    ds_write_b128 v1, v[24:27] offset:3072
    v_max3_f32 v2, v24, v25, v2
    v_max3_f32 v2, v26, v27, v2
    s_waitcnt vmcnt(24)
    s_cmp_gt_i32 s39, 30
    s_cbranch_scc1 L_w16
    s_waitcnt vmcnt(21)
L_w16:
    buffer_load_dwordx4 a[112:115], v122, s[12:15], s20 offen offset:1280 nt
    buffer_load_dwordx4 a[116:119], v122, s[12:15], s20 offen offset:1408 nt
    v_mfma_f32_16x16x32_bf16 v[116:119], a[120:123], v[96:99], 0
    v_mfma_f32_16x16x32_bf16 v[116:119], a[124:127], v[100:103], v[116:119]
    v_add_f32_dpp v28, v112, v113 row_ror:8 row_mask:0xf bank_mask:0xc
    v_add_f32_dpp v29, v114, v115 row_ror:8 row_mask:0xf bank_mask:0xc
    v_add_u32 v1, 0x1000, v1
    s_sub_u32 s33, s33, 1
    s_cmp_gt_i32 s33, 0
    s_cbranch_scc1 L_k
L_peel:
    s_waitcnt vmcnt(24)
    s_cmp_gt_i32 s39, 2
    s_cbranch_scc1 L_w17
    s_waitcnt vmcnt(21)
L_w17:
    s_add_u32 s62, s62, 1
    v_mov_b32 v8, s62
    buffer_store_byte v8, v9, s[56:59], 0 offen
    buffer_load_ubyte v5, v0, s[56:59], 0 offen sc0
    buffer_load_dwordx4 a[120:123], v123, s[12:15], s20 offen offset:1024 nt
    buffer_load_dwordx4 a[124:127], v123, s[12:15], s20 offen offset:1152 nt
    s_mov_b32 s21, 0
    s_mov_b32 s52, 0
    s_mov_b32 s20, s21
    v_mfma_f32_16x16x32_bf16 v[104:107], a[0:3], v[96:99], 0
    v_mfma_f32_16x16x32_bf16 v[104:107], a[4:7], v[100:103], v[104:107]
    v_add_f32_dpp v30, v116, v117 row_ror:8 row_mask:0xf bank_mask:0xc
    v_add_f32_dpp v31, v118, v119 row_ror:8 row_mask:0xf bank_mask:0xc
    ds_write_b128 v1, v[28:31] offset:0
    v_max3_f32 v2, v28, v29, v2
    v_max3_f32 v2, v30, v31, v2
    s_waitcnt vmcnt(24)
    s_cmp_gt_i32 s39, 18
    s_cbranch_scc1 L_w18
    s_waitcnt vmcnt(21)
L_w18:
    buffer_load_dwordx4 v[128:131], v12, s[16:19], s20 offen offset:0 nt
    buffer_load_dwordx4 v[132:135], v13, s[16:19], s20 offen offset:0 nt
    v_mfma_f32_16x16x32_bf16 v[108:111], a[8:11], v[96:99], 0
    v_mfma_f32_16x16x32_bf16 v[108:111], a[12:15], v[100:103], v[108:111]
    v_add_f32_dpp v24, v105, v104 row_ror:8 row_mask:0xf bank_mask:0x3
    v_add_f32_dpp v25, v107, v106 row_ror:8 row_mask:0xf bank_mask:0x3
    s_waitcnt vmcnt(24)
    s_cmp_gt_i32 s39, 10
    s_cbranch_scc1 L_w19
    s_waitcnt vmcnt(21)
L_w19:
    buffer_load_dwordx4 v[136:139], v14, s[16:19], s20 offen offset:256 nt
    buffer_load_dwordx4 v[140:143], v15, s[16:19], s20 offen offset:256 nt
    v_mfma_f32_16x16x32_bf16 v[112:115], a[16:19], v[96:99], 0
    v_mfma_f32_16x16x32_bf16 v[112:115], a[20:23], v[100:103], v[112:115]
    v_add_f32_dpp v26, v109, v108 row_ror:8 row_mask:0xf bank_mask:0x3
    v_add_f32_dpp v27, v111, v110 row_ror:8 row_mask:0xf bank_mask:0x3
    s_waitcnt vmcnt(24)
    s_cmp_gt_i32 s39, 26
    s_cbranch_scc1 L_w20
    s_waitcnt vmcnt(21)
L_w20:
    buffer_load_dwordx4 v[144:147], v16, s[16:19], s20 offen offset:0 nt
    buffer_load_dwordx4 v[148:151], v17, s[16:19], s20 offen offset:0 nt
    v_mfma_f32_16x16x32_bf16 v[116:119], a[24:27], v[96:99], 0
    v_mfma_f32_16x16x32_bf16 v[116:119], a[28:31], v[100:103], v[116:119]
    v_add_f32_dpp v28, v113, v112 row_ror:8 row_mask:0xf bank_mask:0x3
    v_add_f32_dpp v29, v115, v114 row_ror:8 row_mask:0xf bank_mask:0x3
    s_waitcnt vmcnt(24)
    s_cmp_gt_i32 s39, 6
    s_cbranch_scc1 L_w21
    s_waitcnt vmcnt(21)
L_w21:
    v_cmp_lt_i32 vcc, s60, v6
    s_bcnt1_i32_b32 s39, vcc_lo
    s_cmp_lt_i32 s60, 4
    s_cselect_b32 s39, 16, s39
    s_add_u32 s60, s60, 1
    buffer_load_dwordx4 v[152:155], v18, s[16:19], s20 offen offset:256 nt
    buffer_load_dwordx4 v[156:159], v19, s[16:19], s20 offen offset:256 nt
    v_mfma_f32_16x16x32_bf16 v[104:107], a[32:35], v[96:99], 0
    v_mfma_f32_16x16x32_bf16 v[104:107], a[36:39], v[100:103], v[104:107]
    v_add_f32_dpp v30, v117, v116 row_ror:8 row_mask:0xf bank_mask:0x3
    v_add_f32_dpp v31, v119, v118 row_ror:8 row_mask:0xf bank_mask:0x3
    s_waitcnt vmcnt(24)
    s_cmp_gt_i32 s39, 22
    s_cbranch_scc1 L_w22
    s_waitcnt vmcnt(21)
L_w22:
    buffer_load_dwordx4 v[160:163], v12, s[16:19], s20 offen offset:256 nt
    buffer_load_dwordx4 v[164:167], v13, s[16:19], s20 offen offset:256 nt
    v_mfma_f32_16x16x32_bf16 v[108:111], a[40:43], v[96:99], 0
    v_mfma_f32_16x16x32_bf16 v[108:111], a[44:47], v[100:103], v[108:111]
    v_add_f32_dpp v24, v104, v105 row_ror:8 row_mask:0xf bank_mask:0xc
    v_add_f32_dpp v25, v106, v107 row_ror:8 row_mask:0xf bank_mask:0xc
    s_waitcnt vmcnt(24)
    s_cmp_gt_i32 s39, 14
    s_cbranch_scc1 L_w23
    s_waitcnt vmcnt(21)
L_w23:
    buffer_load_dwordx4 v[168:171], v14, s[16:19], s20 offen offset:0 nt
    buffer_load_dwordx4 v[172:175], v15, s[16:19], s20 offen offset:0 nt
    v_mfma_f32_16x16x32_bf16 v[112:115], a[48:51], v[96:99], 0
    v_mfma_f32_16x16x32_bf16 v[112:115], a[52:55], v[100:103], v[112:115]
    v_add_f32_dpp v26, v108, v109 row_ror:8 row_mask:0xf bank_mask:0xc
    v_add_f32_dpp v27, v110, v111 row_ror:8 row_mask:0xf bank_mask:0xc
    ds_write_b128 v1, v[24:27] offset:1024
    v_max3_f32 v2, v24, v25, v2
    v_max3_f32 v2, v26, v27, v2
    s_waitcnt vmcnt(24)
    s_cmp_gt_i32 s39, 30
    s_cbranch_scc1 L_w24
    s_waitcnt vmcnt(21)
L_w24:
    buffer_load_dwordx4 v[176:179], v16, s[16:19], s20 offen offset:256 nt
    buffer_load_dwordx4 v[180:183], v17, s[16:19], s20 offen offset:256 nt
    v_mfma_f32_16x16x32_bf16 v[116:119], a[56:59], v[96:99], 0
    v_mfma_f32_16x16x32_bf16 v[116:119], a[60:63], v[100:103], v[116:119]
    v_add_f32_dpp v28, v112, v113 row_ror:8 row_mask:0xf bank_mask:0xc
    v_add_f32_dpp v29, v114, v115 row_ror:8 row_mask:0xf bank_mask:0xc
    s_waitcnt vmcnt(24)
    s_cmp_gt_i32 s39, 2
    s_cbranch_scc1 L_w25
    s_waitcnt vmcnt(21)
L_w25:
    s_add_u32 s62, s62, 1
    v_mov_b32 v8, s62
    buffer_store_byte v8, v9, s[56:59], 0 offen
    buffer_load_ubyte v6, v0, s[56:59], 0 offen sc0
    buffer_load_dwordx4 v[184:187], v18, s[16:19], s20 offen offset:0 nt
    buffer_load_dwordx4 v[188:191], v19, s[16:19], s20 offen offset:0 nt
    v_mfma_f32_16x16x32_bf16 v[104:107], a[64:67], v[96:99], 0
    v_mfma_f32_16x16x32_bf16 v[104:107], a[68:71], v[100:103], v[104:107]
    v_add_f32_dpp v30, v116, v117 row_ror:8 row_mask:0xf bank_mask:0xc
    v_add_f32_dpp v31, v118, v119 row_ror:8 row_mask:0xf bank_mask:0xc
    ds_write_b128 v1, v[28:31] offset:2048
    v_max3_f32 v2, v28, v29, v2
    v_max3_f32 v2, v30, v31, v2
    s_waitcnt vmcnt(24)
    s_cmp_gt_i32 s39, 18
    s_cbranch_scc1 L_w26
    s_waitcnt vmcnt(21)
L_w26:
    buffer_load_dwordx4 v[192:195], v12, s[16:19], s20 offen offset:1024 nt
    buffer_load_dwordx4 v[196:199], v13, s[16:19], s20 offen offset:1024 nt
    v_mfma_f32_16x16x32_bf16 v[108:111], a[72:75], v[96:99], 0
    v_mfma_f32_16x16x32_bf16 v[108:111], a[76:79], v[100:103], v[108:111]
    v_add_f32_dpp v24, v105, v104 row_ror:8 row_mask:0xf bank_mask:0x3
    v_add_f32_dpp v25, v107, v106 row_ror:8 row_mask:0xf bank_mask:0x3
    s_waitcnt vmcnt(24)
    s_cmp_gt_i32 s39, 10
    s_cbranch_scc1 L_w27
    s_waitcnt vmcnt(21)
L_w27:
    buffer_load_dwordx4 v[200:203], v14, s[16:19], s20 offen offset:1280 nt
    buffer_load_dwordx4 v[204:207], v15, s[16:19], s20 offen offset:1280 nt
    v_mfma_f32_16x16x32_bf16 v[112:115], a[80:83], v[96:99], 0
    v_mfma_f32_16x16x32_bf16 v[112:115], a[84:87], v[100:103], v[112:115]
    v_add_f32_dpp v26, v109, v108 row_ror:8 row_mask:0xf bank_mask:0x3
    v_add_f32_dpp v27, v111, v110 row_ror:8 row_mask:0xf bank_mask:0x3
    s_waitcnt vmcnt(24)
    s_cmp_gt_i32 s39, 26
    s_cbranch_scc1 L_w28
    s_waitcnt vmcnt(21)
L_w28:
    buffer_load_dwordx4 v[208:211], v16, s[16:19], s20 offen offset:1024 nt
    buffer_load_dwordx4 v[212:215], v17, s[16:19], s20 offen offset:1024 nt
    v_mfma_f32_16x16x32_bf16 v[116:119], a[88:91], v[96:99], 0
    v_mfma_f32_16x16x32_bf16 v[116:119], a[92:95], v[100:103], v[116:119]
    v_add_f32_dpp v28, v113, v112 row_ror:8 row_mask:0xf bank_mask:0x3
    v_add_f32_dpp v29, v115, v114 row_ror:8 row_mask:0xf bank_mask:0x3
    s_waitcnt vmcnt(24)
    s_cmp_gt_i32 s39, 6
    s_cbranch_scc1 L_w29
    s_waitcnt vmcnt(21)
L_w29:
    v_cmp_lt_i32 vcc, s60, v5
    s_bcnt1_i32_b32 s39, vcc_lo
    s_cmp_lt_i32 s60, 4
    s_cselect_b32 s39, 16, s39
    s_add_u32 s60, s60, 1
    buffer_load_dwordx4 v[216:219], v18, s[16:19], s20 offen offset:1280 nt
    buffer_load_dwordx4 v[220:223], v19, s[16:19], s20 offen offset:1280 nt
    v_mfma_f32_16x16x32_bf16 v[104:107], a[96:99], v[96:99], 0
    v_mfma_f32_16x16x32_bf16 v[104:107], a[100:103], v[100:103], v[104:107]
    v_add_f32_dpp v30, v117, v116 row_ror:8 row_mask:0xf bank_mask:0x3
    v_add_f32_dpp v31, v119, v118 row_ror:8 row_mask:0xf bank_mask:0x3
    s_waitcnt vmcnt(24)
    s_cmp_gt_i32 s39, 22
    s_cbranch_scc1 L_w30
    s_waitcnt vmcnt(21)
L_w30:
    buffer_load_dwordx4 v[224:227], v12, s[16:19], s20 offen offset:1280 nt
    buffer_load_dwordx4 v[228:231], v13, s[16:19], s20 offen offset:1280 nt
    s_add_u32 s52, s52, 1
    v_readlane_b32 s21, v11, s52
    v_mfma_f32_16x16x32_bf16 v[108:111], a[104:107], v[96:99], 0
    v_mfma_f32_16x16x32_bf16 v[108:111], a[108:111], v[100:103], v[108:111]
    v_add_f32_dpp v24, v104, v105 row_ror:8 row_mask:0xf bank_mask:0xc
    v_add_f32_dpp v25, v106, v107 row_ror:8 row_mask:0xf bank_mask:0xc
    s_waitcnt vmcnt(24)
    s_cmp_gt_i32 s39, 14
    s_cbranch_scc1 L_w31
    s_waitcnt vmcnt(21)
L_w31:
    buffer_load_dwordx4 v[232:235], v14, s[16:19], s20 offen offset:1024 nt
    buffer_load_dwordx4 v[236:239], v15, s[16:19], s20 offen offset:1024 nt
    v_mfma_f32_16x16x32_bf16 v[112:115], a[112:115], v[96:99], 0
    v_mfma_f32_16x16x32_bf16 v[112:115], a[116:119], v[100:103], v[112:115]
    v_add_f32_dpp v26, v108, v109 row_ror:8 row_mask:0xf bank_mask:0xc
    v_add_f32_dpp v27, v110, v111 row_ror:8 row_mask:0xf bank_mask:0xc
    ds_write_b128 v1, v[24:27] offset:3072
    v_max3_f32 v2, v24, v25, v2
    v_max3_f32 v2, v26, v27, v2
    s_waitcnt vmcnt(24)
    s_cmp_gt_i32 s39, 30
    s_cbranch_scc1 L_w32
    s_waitcnt vmcnt(21)
L_w32:
    buffer_load_dwordx4 v[240:243], v16, s[16:19], s20 offen offset:1280 nt
    buffer_load_dwordx4 v[244:247], v17, s[16:19], s20 offen offset:1280 nt
    v_mfma_f32_16x16x32_bf16 v[116:119], a[120:123], v[96:99], 0
    v_mfma_f32_16x16x32_bf16 v[116:119], a[124:127], v[100:103], v[116:119]
    v_add_f32_dpp v28, v112, v113 row_ror:8 row_mask:0xf bank_mask:0xc
    v_add_f32_dpp v29, v114, v115 row_ror:8 row_mask:0xf bank_mask:0xc
L_mid:
    s_cmp_lt_u32 s54, 64
    s_cselect_b32 s33, 31, 1
    s_nop 3
    v_add_f32_dpp v30, v116, v117 row_ror:8 row_mask:0xf bank_mask:0xc
    v_add_f32_dpp v31, v118, v119 row_ror:8 row_mask:0xf bank_mask:0xc
    ds_write_b128 v1, v[28:31] offset:4096
    v_max3_f32 v2, v28, v29, v2
    v_max3_f32 v2, v30, v31, v2
    v_lshlrev_b32 v1, 4, v0
    v_mov_b32 v4, v2
    ds_read_b128 v[24:27], v1 offset:1024
    ds_read_b128 v[28:31], v1 offset:2048
    v_permlane32_swap_b32 v2, v4
    v_max_f32 v2, v2, v4
    v_mov_b32 v4, v2
    s_nop 1
    v_permlane16_swap_b32 v2, v4
    v_max_f32 v2, v2, v4
    s_nop 1
    v_max_f32_dpp v2, v2, v2 row_ror:8 row_mask:0xf bank_mask:0xf
    v_mul_f32 v2, s22, v2
    s_waitcnt lgkmcnt(0)
    v_pk_fma_f32 v[24:25], v[24:25], s[22:23], v[2:3] op_sel_hi:[1,0,0] neg_lo:[0,0,1] neg_hi:[0,0,1]
    v_pk_fma_f32 v[26:27], v[26:27], s[22:23], v[2:3] op_sel_hi:[1,0,0] neg_lo:[0,0,1] neg_hi:[0,0,1]
    v_pk_fma_f32 v[28:29], v[28:29], s[22:23], v[2:3] op_sel_hi:[1,0,0] neg_lo:[0,0,1] neg_hi:[0,0,1]
    v_pk_fma_f32 v[30:31], v[30:31], s[22:23], v[2:3] op_sel_hi:[1,0,0] neg_lo:[0,0,1] neg_hi:[0,0,1]
    v_exp_f32 v24, v24
    v_exp_f32 v25, v25
    v_exp_f32 v26, v26
    v_exp_f32 v27, v27
    v_exp_f32 v28, v28
    v_exp_f32 v29, v29
    v_exp_f32 v30, v30
    v_exp_f32 v31, v31
L_v:
    s_waitcnt vmcnt(24)
    s_cmp_gt_i32 s39, 2
    s_cbranch_scc1 L_w33
    s_waitcnt vmcnt(21)
L_w33:
    s_add_u32 s62, s62, 1
    v_mov_b32 v8, s62
    buffer_store_byte v8, v9, s[56:59], 0 offen
    buffer_load_ubyte v5, v0, s[56:59], 0 offen sc0
    buffer_load_dwordx4 v[248:251], v18, s[16:19], s20 offen offset:1024 nt
    buffer_load_dwordx4 v[252:255], v19, s[16:19], s20 offen offset:1024 nt
    s_mov_b32 s20, s21
    v_perm_b32 v96, v132, v128, s34
    v_cvt_pk_bf16_f32 v20, v24, v25
    v_perm_b32 v100, v132, v128, s32
    v_cvt_pk_bf16_f32 v21, v26, v27
    v_perm_b32 v104, v133, v129, s34
    v_cvt_pk_bf16_f32 v22, v28, v29
    v_perm_b32 v108, v133, v129, s32
    v_cvt_pk_bf16_f32 v23, v30, v31
    v_perm_b32 v112, v134, v130, s34
    ds_read_b128 v[24:27], v1 offset:3072
    v_perm_b32 v116, v134, v130, s32
    ds_read_b128 v[28:31], v1 offset:4096
    v_perm_b32 v120, v135, v131, s34
    v_perm_b32 v124, v135, v131, s32
    s_waitcnt vmcnt(24)
    s_cmp_gt_i32 s39, 18
    s_cbranch_scc1 L_w34
    s_waitcnt vmcnt(21)
L_w34:
    buffer_load_dwordx4 v[128:131], v12, s[16:19], s20 offen offset:0 nt
    buffer_load_dwordx4 v[132:135], v13, s[16:19], s20 offen offset:0 nt
    v_perm_b32 v97, v140, v136, s34
    v_mfma_f32_16x16x32_bf16 a[128:131], a[132:135], v[20:23], a[128:131]
    v_perm_b32 v101, v140, v136, s32
    v_perm_b32 v105, v141, v137, s34
    v_perm_b32 v109, v141, v137, s32
    v_perm_b32 v113, v142, v138, s34
    v_perm_b32 v117, v142, v138, s32
    v_perm_b32 v121, v143, v139, s34
    v_perm_b32 v125, v143, v139, s32
    s_waitcnt vmcnt(24)
    s_cmp_gt_i32 s39, 10
    s_cbranch_scc1 L_w35
    s_waitcnt vmcnt(21)
L_w35:
    buffer_load_dwordx4 v[136:139], v14, s[16:19], s20 offen offset:256 nt
    buffer_load_dwordx4 v[140:143], v15, s[16:19], s20 offen offset:256 nt
    v_perm_b32 v98, v148, v144, s34
    s_waitcnt lgkmcnt(0)
    v_perm_b32 v102, v148, v144, s32
    v_pk_fma_f32 v[24:25], v[24:25], s[22:23], v[2:3] op_sel_hi:[1,0,0] neg_lo:[0,0,1] neg_hi:[0,0,1]
    v_perm_b32 v106, v149, v145, s34
    v_perm_b32 v110, v149, v145, s32
    v_pk_fma_f32 v[26:27], v[26:27], s[22:23], v[2:3] op_sel_hi:[1,0,0] neg_lo:[0,0,1] neg_hi:[0,0,1]
    v_perm_b32 v114, v150, v146, s34
    v_perm_b32 v118, v150, v146, s32
    v_pk_fma_f32 v[28:29], v[28:29], s[22:23], v[2:3] op_sel_hi:[1,0,0] neg_lo:[0,0,1] neg_hi:[0,0,1]
    v_perm_b32 v122, v151, v147, s34
    v_perm_b32 v126, v151, v147, s32
    v_pk_fma_f32 v[30:31], v[30:31], s[22:23], v[2:3] op_sel_hi:[1,0,0] neg_lo:[0,0,1] neg_hi:[0,0,1]
    s_waitcnt vmcnt(24)
    s_cmp_gt_i32 s39, 26
    s_cbranch_scc1 L_w36
    s_waitcnt vmcnt(21)
L_w36:
    buffer_load_dwordx4 v[144:147], v16, s[16:19], s20 offen offset:0 nt
    buffer_load_dwordx4 v[148:151], v17, s[16:19], s20 offen offset:0 nt
    v_perm_b32 v99, v156, v152, s34
    v_perm_b32 v103, v156, v152, s32
    v_perm_b32 v107, v157, v153, s34
    v_mfma_f32_16x16x32_bf16 v[32:35], v[96:99], v[20:23], v[32:35]
    v_perm_b32 v111, v157, v153, s32
    v_mfma_f32_16x16x32_bf16 v[36:39], v[100:103], v[20:23], v[36:39]
    v_perm_b32 v115, v158, v154, s34
    v_mfma_f32_16x16x32_bf16 v[40:43], v[104:107], v[20:23], v[40:43]
    v_perm_b32 v119, v158, v154, s32
    v_mfma_f32_16x16x32_bf16 v[44:47], v[108:111], v[20:23], v[44:47]
    v_perm_b32 v123, v159, v155, s34
    v_mfma_f32_16x16x32_bf16 v[48:51], v[112:115], v[20:23], v[48:51]
    v_perm_b32 v127, v159, v155, s32
    v_mfma_f32_16x16x32_bf16 v[52:55], v[116:119], v[20:23], v[52:55]
    v_mfma_f32_16x16x32_bf16 v[56:59], v[120:123], v[20:23], v[56:59]
    v_mfma_f32_16x16x32_bf16 v[60:63], v[124:127], v[20:23], v[60:63]
    s_waitcnt vmcnt(24)
    s_cmp_gt_i32 s39, 6
    s_cbranch_scc1 L_w37
    s_waitcnt vmcnt(21)
L_w37:
    v_cmp_lt_i32 vcc, s60, v6
    s_bcnt1_i32_b32 s39, vcc_lo
    s_cmp_lt_i32 s60, 4
    s_cselect_b32 s39, 16, s39
    s_add_u32 s60, s60, 1
    buffer_load_dwordx4 v[152:155], v18, s[16:19], s20 offen offset:256 nt
    buffer_load_dwordx4 v[156:159], v19, s[16:19], s20 offen offset:256 nt
    v_perm_b32 v96, v164, v160, s34
    v_perm_b32 v100, v164, v160, s32
    v_exp_f32 v24, v24
    v_perm_b32 v104, v165, v161, s34
    v_perm_b32 v108, v165, v161, s32
    v_exp_f32 v25, v25
    v_perm_b32 v112, v166, v162, s34
    v_perm_b32 v116, v166, v162, s32
    v_exp_f32 v26, v26
    v_perm_b32 v120, v167, v163, s34
    v_perm_b32 v124, v167, v163, s32
    s_waitcnt vmcnt(24)
    s_cmp_gt_i32 s39, 22
    s_cbranch_scc1 L_w38
    s_waitcnt vmcnt(21)
L_w38:
    buffer_load_dwordx4 v[160:163], v12, s[16:19], s20 offen offset:256 nt
    buffer_load_dwordx4 v[164:167], v13, s[16:19], s20 offen offset:256 nt
    v_perm_b32 v97, v172, v168, s34
    v_perm_b32 v101, v172, v168, s32
    v_exp_f32 v27, v27
    v_perm_b32 v105, v173, v169, s34
    v_perm_b32 v109, v173, v169, s32
    v_exp_f32 v28, v28
    v_perm_b32 v113, v174, v170, s34
    v_perm_b32 v117, v174, v170, s32
    v_exp_f32 v29, v29
    v_perm_b32 v121, v175, v171, s34
    v_perm_b32 v125, v175, v171, s32
    s_waitcnt vmcnt(24)
    s_cmp_gt_i32 s39, 14
    s_cbranch_scc1 L_w39
    s_waitcnt vmcnt(21)
L_w39:
    buffer_load_dwordx4 v[168:171], v14, s[16:19], s20 offen offset:0 nt
    buffer_load_dwordx4 v[172:175], v15, s[16:19], s20 offen offset:0 nt
    v_perm_b32 v98, v180, v176, s34
    v_perm_b32 v102, v180, v176, s32
    v_exp_f32 v30, v30
    v_perm_b32 v106, v181, v177, s34
    v_perm_b32 v110, v181, v177, s32
    v_exp_f32 v31, v31
    v_perm_b32 v114, v182, v178, s34
    v_perm_b32 v118, v182, v178, s32
    v_perm_b32 v122, v183, v179, s34
    v_perm_b32 v126, v183, v179, s32
    s_waitcnt vmcnt(24)
    s_cmp_gt_i32 s39, 30
    s_cbranch_scc1 L_w40
    s_waitcnt vmcnt(21)
L_w40:
    buffer_load_dwordx4 v[176:179], v16, s[16:19], s20 offen offset:256 nt
    buffer_load_dwordx4 v[180:183], v17, s[16:19], s20 offen offset:256 nt
    v_perm_b32 v99, v188, v184, s34
    v_perm_b32 v103, v188, v184, s32
    v_perm_b32 v107, v189, v185, s34
    v_mfma_f32_16x16x32_bf16 v[64:67], v[96:99], v[20:23], v[64:67]
    v_perm_b32 v111, v189, v185, s32
    v_mfma_f32_16x16x32_bf16 v[68:71], v[100:103], v[20:23], v[68:71]
    v_perm_b32 v115, v190, v186, s34
    v_mfma_f32_16x16x32_bf16 v[72:75], v[104:107], v[20:23], v[72:75]
    v_perm_b32 v119, v190, v186, s32
    v_mfma_f32_16x16x32_bf16 v[76:79], v[108:111], v[20:23], v[76:79]
    v_perm_b32 v123, v191, v187, s34
    v_mfma_f32_16x16x32_bf16 v[80:83], v[112:115], v[20:23], v[80:83]
    v_perm_b32 v127, v191, v187, s32
    v_mfma_f32_16x16x32_bf16 v[84:87], v[116:119], v[20:23], v[84:87]
    v_mfma_f32_16x16x32_bf16 v[88:91], v[120:123], v[20:23], v[88:91]
    v_mfma_f32_16x16x32_bf16 v[92:95], v[124:127], v[20:23], v[92:95]
    s_waitcnt vmcnt(24)
    s_cmp_gt_i32 s39, 2
    s_cbranch_scc1 L_w41
    s_waitcnt vmcnt(21)
L_w41:
    s_add_u32 s62, s62, 1
    v_mov_b32 v8, s62
    buffer_store_byte v8, v9, s[56:59], 0 offen
    buffer_load_ubyte v6, v0, s[56:59], 0 offen sc0
    buffer_load_dwordx4 v[184:187], v18, s[16:19], s20 offen offset:0 nt
    buffer_load_dwordx4 v[188:191], v19, s[16:19], s20 offen offset:0 nt
    v_perm_b32 v96, v196, v192, s34
    v_cvt_pk_bf16_f32 v20, v24, v25
    v_perm_b32 v100, v196, v192, s32
    v_cvt_pk_bf16_f32 v21, v26, v27
    v_perm_b32 v104, v197, v193, s34
    v_cvt_pk_bf16_f32 v22, v28, v29
    v_perm_b32 v108, v197, v193, s32
    v_cvt_pk_bf16_f32 v23, v30, v31
    v_perm_b32 v112, v198, v194, s34
    ds_read_b128 v[24:27], v1 offset:5120
    v_perm_b32 v116, v198, v194, s32
    ds_read_b128 v[28:31], v1 offset:6144
    v_perm_b32 v120, v199, v195, s34
    v_perm_b32 v124, v199, v195, s32
    s_waitcnt vmcnt(24)
    s_cmp_gt_i32 s39, 18
    s_cbranch_scc1 L_w42
    s_waitcnt vmcnt(21)
L_w42:
    buffer_load_dwordx4 v[192:195], v12, s[16:19], s20 offen offset:1024 nt
    buffer_load_dwordx4 v[196:199], v13, s[16:19], s20 offen offset:1024 nt
    v_perm_b32 v97, v204, v200, s34
    v_mfma_f32_16x16x32_bf16 a[128:131], a[132:135], v[20:23], a[128:131]
    v_perm_b32 v101, v204, v200, s32
    v_perm_b32 v105, v205, v201, s34
    v_perm_b32 v109, v205, v201, s32
    v_perm_b32 v113, v206, v202, s34
    v_perm_b32 v117, v206, v202, s32
    v_perm_b32 v121, v207, v203, s34
    v_perm_b32 v125, v207, v203, s32
    s_waitcnt vmcnt(24)
    s_cmp_gt_i32 s39, 10
    s_cbranch_scc1 L_w43
    s_waitcnt vmcnt(21)
L_w43:
    buffer_load_dwordx4 v[200:203], v14, s[16:19], s20 offen offset:1280 nt
    buffer_load_dwordx4 v[204:207], v15, s[16:19], s20 offen offset:1280 nt
    v_perm_b32 v98, v212, v208, s34
    s_waitcnt lgkmcnt(0)
    v_perm_b32 v102, v212, v208, s32
    v_pk_fma_f32 v[24:25], v[24:25], s[22:23], v[2:3] op_sel_hi:[1,0,0] neg_lo:[0,0,1] neg_hi:[0,0,1]
    v_perm_b32 v106, v213, v209, s34
    v_perm_b32 v110, v213, v209, s32
    v_pk_fma_f32 v[26:27], v[26:27], s[22:23], v[2:3] op_sel_hi:[1,0,0] neg_lo:[0,0,1] neg_hi:[0,0,1]
    v_perm_b32 v114, v214, v210, s34
    v_perm_b32 v118, v214, v210, s32
    v_pk_fma_f32 v[28:29], v[28:29], s[22:23], v[2:3] op_sel_hi:[1,0,0] neg_lo:[0,0,1] neg_hi:[0,0,1]
    v_perm_b32 v122, v215, v211, s34
    v_perm_b32 v126, v215, v211, s32
    v_pk_fma_f32 v[30:31], v[30:31], s[22:23], v[2:3] op_sel_hi:[1,0,0] neg_lo:[0,0,1] neg_hi:[0,0,1]
    s_waitcnt vmcnt(24)
    s_cmp_gt_i32 s39, 26
    s_cbranch_scc1 L_w44
    s_waitcnt vmcnt(21)
L_w44:
    buffer_load_dwordx4 v[208:211], v16, s[16:19], s20 offen offset:1024 nt
    buffer_load_dwordx4 v[212:215], v17, s[16:19], s20 offen offset:1024 nt
    v_perm_b32 v99, v220, v216, s34
    v_perm_b32 v103, v220, v216, s32
    v_perm_b32 v107, v221, v217, s34
    v_mfma_f32_16x16x32_bf16 v[32:35], v[96:99], v[20:23], v[32:35]
    v_perm_b32 v111, v221, v217, s32
    v_mfma_f32_16x16x32_bf16 v[36:39], v[100:103], v[20:23], v[36:39]
    v_perm_b32 v115, v222, v218, s34
    v_mfma_f32_16x16x32_bf16 v[40:43], v[104:107], v[20:23], v[40:43]
    v_perm_b32 v119, v222, v218, s32
    v_mfma_f32_16x16x32_bf16 v[44:47], v[108:111], v[20:23], v[44:47]
    v_perm_b32 v123, v223, v219, s34
    v_mfma_f32_16x16x32_bf16 v[48:51], v[112:115], v[20:23], v[48:51]
    v_perm_b32 v127, v223, v219, s32
    v_mfma_f32_16x16x32_bf16 v[52:55], v[116:119], v[20:23], v[52:55]
    v_mfma_f32_16x16x32_bf16 v[56:59], v[120:123], v[20:23], v[56:59]
    v_mfma_f32_16x16x32_bf16 v[60:63], v[124:127], v[20:23], v[60:63]
    s_waitcnt vmcnt(24)
    s_cmp_gt_i32 s39, 6
    s_cbranch_scc1 L_w45
    s_waitcnt vmcnt(21)
L_w45:
    v_cmp_lt_i32 vcc, s60, v5
    s_bcnt1_i32_b32 s39, vcc_lo
    s_cmp_lt_i32 s60, 4
    s_cselect_b32 s39, 16, s39
    s_add_u32 s60, s60, 1
    buffer_load_dwordx4 v[216:219], v18, s[16:19], s20 offen offset:1280 nt
    buffer_load_dwordx4 v[220:223], v19, s[16:19], s20 offen offset:1280 nt
    v_perm_b32 v96, v228, v224, s34
    v_perm_b32 v100, v228, v224, s32
    v_exp_f32 v24, v24
    v_perm_b32 v104, v229, v225, s34
    v_perm_b32 v108, v229, v225, s32
    v_exp_f32 v25, v25
    v_perm_b32 v112, v230, v226, s34
    v_perm_b32 v116, v230, v226, s32
    v_exp_f32 v26, v26
    v_perm_b32 v120, v231, v227, s34
    v_perm_b32 v124, v231, v227, s32
    s_waitcnt vmcnt(24)
    s_cmp_gt_i32 s39, 22
    s_cbranch_scc1 L_w46
    s_waitcnt vmcnt(21)
L_w46:
    buffer_load_dwordx4 v[224:227], v12, s[16:19], s20 offen offset:1280 nt
    buffer_load_dwordx4 v[228:231], v13, s[16:19], s20 offen offset:1280 nt
    s_add_u32 s52, s52, 1
    v_readlane_b32 s21, v11, s52
    v_perm_b32 v97, v236, v232, s34
    v_perm_b32 v101, v236, v232, s32
    v_exp_f32 v27, v27
    v_perm_b32 v105, v237, v233, s34
    v_perm_b32 v109, v237, v233, s32
    v_exp_f32 v28, v28
    v_perm_b32 v113, v238, v234, s34
    v_perm_b32 v117, v238, v234, s32
    v_exp_f32 v29, v29
    v_perm_b32 v121, v239, v235, s34
    v_perm_b32 v125, v239, v235, s32
    s_waitcnt vmcnt(24)
    s_cmp_gt_i32 s39, 14
    s_cbranch_scc1 L_w47
    s_waitcnt vmcnt(21)
L_w47:
    buffer_load_dwordx4 v[232:235], v14, s[16:19], s20 offen offset:1024 nt
    buffer_load_dwordx4 v[236:239], v15, s[16:19], s20 offen offset:1024 nt
    v_perm_b32 v98, v244, v240, s34
    v_perm_b32 v102, v244, v240, s32
    v_exp_f32 v30, v30
    v_perm_b32 v106, v245, v241, s34
    v_perm_b32 v110, v245, v241, s32
    v_exp_f32 v31, v31
    v_perm_b32 v114, v246, v242, s34
    v_perm_b32 v118, v246, v242, s32
    v_perm_b32 v122, v247, v243, s34
    v_perm_b32 v126, v247, v243, s32
    s_waitcnt vmcnt(24)
    s_cmp_gt_i32 s39, 30
    s_cbranch_scc1 L_w48
    s_waitcnt vmcnt(21)
L_w48:
    buffer_load_dwordx4 v[240:243], v16, s[16:19], s20 offen offset:1280 nt
    buffer_load_dwordx4 v[244:247], v17, s[16:19], s20 offen offset:1280 nt
    v_perm_b32 v99, v252, v248, s34
    v_perm_b32 v103, v252, v248, s32
    v_perm_b32 v107, v253, v249, s34
    v_mfma_f32_16x16x32_bf16 v[64:67], v[96:99], v[20:23], v[64:67]
    v_perm_b32 v111, v253, v249, s32
    v_mfma_f32_16x16x32_bf16 v[68:71], v[100:103], v[20:23], v[68:71]
    v_perm_b32 v115, v254, v250, s34
    v_mfma_f32_16x16x32_bf16 v[72:75], v[104:107], v[20:23], v[72:75]
    v_perm_b32 v119, v254, v250, s32
    v_mfma_f32_16x16x32_bf16 v[76:79], v[108:111], v[20:23], v[76:79]
    v_perm_b32 v123, v255, v251, s34
    v_mfma_f32_16x16x32_bf16 v[80:83], v[112:115], v[20:23], v[80:83]
    v_perm_b32 v127, v255, v251, s32
    v_mfma_f32_16x16x32_bf16 v[84:87], v[116:119], v[20:23], v[84:87]
    v_mfma_f32_16x16x32_bf16 v[88:91], v[120:123], v[20:23], v[88:91]
    v_mfma_f32_16x16x32_bf16 v[92:95], v[124:127], v[20:23], v[92:95]
    v_add_u32 v1, 0x1000, v1
    s_sub_u32 s33, s33, 1
    s_cmp_gt_i32 s33, 0
    s_cbranch_scc1 L_v
L_epi:
    s_waitcnt vmcnt(28)
    buffer_load_dwordx4 v[248:251], v18, s[16:19], s20 offen offset:1024 nt
    buffer_load_dwordx4 v[252:255], v19, s[16:19], s20 offen offset:1024 nt
    v_perm_b32 v96, v132, v128, s34
    v_cvt_pk_bf16_f32 v20, v24, v25
    v_perm_b32 v100, v132, v128, s32
    v_cvt_pk_bf16_f32 v21, v26, v27
    v_perm_b32 v104, v133, v129, s34
    v_cvt_pk_bf16_f32 v22, v28, v29
    v_perm_b32 v108, v133, v129, s32
    v_cvt_pk_bf16_f32 v23, v30, v31
    v_perm_b32 v112, v134, v130, s34
    ds_read_b128 v[24:27], v1 offset:3072
    v_perm_b32 v116, v134, v130, s32
    ds_read_b128 v[28:31], v1 offset:4096
    v_perm_b32 v120, v135, v131, s34
    v_perm_b32 v124, v135, v131, s32
    s_waitcnt vmcnt(28)
    v_perm_b32 v97, v140, v136, s34
    v_mfma_f32_16x16x32_bf16 a[128:131], a[132:135], v[20:23], a[128:131]
    v_perm_b32 v101, v140, v136, s32
    v_perm_b32 v105, v141, v137, s34
    v_perm_b32 v109, v141, v137, s32
    v_perm_b32 v113, v142, v138, s34
    v_perm_b32 v117, v142, v138, s32
    v_perm_b32 v121, v143, v139, s34
    v_perm_b32 v125, v143, v139, s32
    s_waitcnt vmcnt(26)
    v_perm_b32 v98, v148, v144, s34
    s_waitcnt lgkmcnt(0)
    v_perm_b32 v102, v148, v144, s32
    v_pk_fma_f32 v[24:25], v[24:25], s[22:23], v[2:3] op_sel_hi:[1,0,0] neg_lo:[0,0,1] neg_hi:[0,0,1]
    v_perm_b32 v106, v149, v145, s34
    v_perm_b32 v110, v149, v145, s32
    v_pk_fma_f32 v[26:27], v[26:27], s[22:23], v[2:3] op_sel_hi:[1,0,0] neg_lo:[0,0,1] neg_hi:[0,0,1]
    v_perm_b32 v114, v150, v146, s34
    v_perm_b32 v118, v150, v146, s32
    v_pk_fma_f32 v[28:29], v[28:29], s[22:23], v[2:3] op_sel_hi:[1,0,0] neg_lo:[0,0,1] neg_hi:[0,0,1]
    v_perm_b32 v122, v151, v147, s34
    v_perm_b32 v126, v151, v147, s32
    v_pk_fma_f32 v[30:31], v[30:31], s[22:23], v[2:3] op_sel_hi:[1,0,0] neg_lo:[0,0,1] neg_hi:[0,0,1]
    s_waitcnt vmcnt(24)
    v_perm_b32 v99, v156, v152, s34
    v_perm_b32 v103, v156, v152, s32
    v_perm_b32 v107, v157, v153, s34
    v_perm_b32 v111, v157, v153, s32
    v_exp_f32 v24, v24
    v_perm_b32 v115, v158, v154, s34
    v_perm_b32 v119, v158, v154, s32
    v_perm_b32 v123, v159, v155, s34
    v_perm_b32 v127, v159, v155, s32
    v_exp_f32 v25, v25
    s_waitcnt vmcnt(22)
    v_perm_b32 v128, v164, v160, s34
    v_perm_b32 v132, v164, v160, s32
    v_mfma_f32_16x16x32_bf16 v[32:35], v[96:99], v[20:23], v[32:35]
    v_perm_b32 v136, v165, v161, s34
    v_perm_b32 v140, v165, v161, s32
    v_exp_f32 v26, v26
    v_perm_b32 v144, v166, v162, s34
    v_perm_b32 v148, v166, v162, s32
    v_mfma_f32_16x16x32_bf16 v[36:39], v[100:103], v[20:23], v[36:39]
    v_perm_b32 v152, v167, v163, s34
    v_perm_b32 v156, v167, v163, s32
    v_exp_f32 v27, v27
    s_waitcnt vmcnt(20)
    v_perm_b32 v129, v172, v168, s34
    v_perm_b32 v133, v172, v168, s32
    v_mfma_f32_16x16x32_bf16 v[40:43], v[104:107], v[20:23], v[40:43]
    v_perm_b32 v137, v173, v169, s34
    v_perm_b32 v141, v173, v169, s32
    v_exp_f32 v28, v28
    v_perm_b32 v145, v174, v170, s34
    v_perm_b32 v149, v174, v170, s32
    v_mfma_f32_16x16x32_bf16 v[44:47], v[108:111], v[20:23], v[44:47]
    v_perm_b32 v153, v175, v171, s34
    v_perm_b32 v157, v175, v171, s32
    v_exp_f32 v29, v29
    s_waitcnt vmcnt(18)
    v_perm_b32 v130, v180, v176, s34
    v_perm_b32 v134, v180, v176, s32
    v_mfma_f32_16x16x32_bf16 v[48:51], v[112:115], v[20:23], v[48:51]
    v_perm_b32 v138, v181, v177, s34
    v_perm_b32 v142, v181, v177, s32
    v_exp_f32 v30, v30
    v_perm_b32 v146, v182, v178, s34
    v_perm_b32 v150, v182, v178, s32
    v_mfma_f32_16x16x32_bf16 v[52:55], v[116:119], v[20:23], v[52:55]
    v_perm_b32 v154, v183, v179, s34
    v_perm_b32 v158, v183, v179, s32
    v_exp_f32 v31, v31
    s_waitcnt vmcnt(16)
    v_perm_b32 v131, v188, v184, s34
    v_perm_b32 v135, v188, v184, s32
    v_mfma_f32_16x16x32_bf16 v[56:59], v[120:123], v[20:23], v[56:59]
    v_perm_b32 v139, v189, v185, s34
    v_perm_b32 v143, v189, v185, s32
    v_perm_b32 v147, v190, v186, s34
    v_perm_b32 v151, v190, v186, s32
    v_mfma_f32_16x16x32_bf16 v[60:63], v[124:127], v[20:23], v[60:63]
    v_perm_b32 v155, v191, v187, s34
    v_perm_b32 v159, v191, v187, s32
    s_waitcnt vmcnt(14)
    v_perm_b32 v96, v196, v192, s34
    v_cvt_pk_bf16_f32 v160, v24, v25
    v_perm_b32 v100, v196, v192, s32
    v_cvt_pk_bf16_f32 v161, v26, v27
    v_mfma_f32_16x16x32_bf16 v[64:67], v[128:131], v[20:23], v[64:67]
    v_perm_b32 v104, v197, v193, s34
    v_cvt_pk_bf16_f32 v162, v28, v29
    v_perm_b32 v108, v197, v193, s32
    v_cvt_pk_bf16_f32 v163, v30, v31
    v_perm_b32 v112, v198, v194, s34
    v_perm_b32 v116, v198, v194, s32
    v_mfma_f32_16x16x32_bf16 v[68:71], v[132:135], v[20:23], v[68:71]
    v_perm_b32 v120, v199, v195, s34
    v_perm_b32 v124, v199, v195, s32
    s_waitcnt vmcnt(12)
    v_perm_b32 v97, v204, v200, s34
    v_perm_b32 v101, v204, v200, s32
    v_mfma_f32_16x16x32_bf16 v[72:75], v[136:139], v[20:23], v[72:75]
    v_perm_b32 v105, v205, v201, s34
    v_perm_b32 v109, v205, v201, s32
    v_mfma_f32_16x16x32_bf16 a[128:131], a[132:135], v[160:163], a[128:131]
    v_perm_b32 v113, v206, v202, s34
    v_perm_b32 v117, v206, v202, s32
    v_mfma_f32_16x16x32_bf16 v[76:79], v[140:143], v[20:23], v[76:79]
    v_perm_b32 v121, v207, v203, s34
    v_perm_b32 v125, v207, v203, s32
    s_waitcnt vmcnt(10)
    v_perm_b32 v98, v212, v208, s34
    v_perm_b32 v102, v212, v208, s32
    v_mfma_f32_16x16x32_bf16 v[80:83], v[144:147], v[20:23], v[80:83]
    v_perm_b32 v106, v213, v209, s34
    v_perm_b32 v110, v213, v209, s32
    v_perm_b32 v114, v214, v210, s34
    v_perm_b32 v118, v214, v210, s32
    v_mfma_f32_16x16x32_bf16 v[84:87], v[148:151], v[20:23], v[84:87]
    v_perm_b32 v122, v215, v211, s34
    v_perm_b32 v126, v215, v211, s32
    s_waitcnt vmcnt(8)
    v_perm_b32 v99, v220, v216, s34
    v_perm_b32 v103, v220, v216, s32
    v_mfma_f32_16x16x32_bf16 v[88:91], v[152:155], v[20:23], v[88:91]
    v_perm_b32 v107, v221, v217, s34
    v_perm_b32 v111, v221, v217, s32
    v_perm_b32 v115, v222, v218, s34
    v_perm_b32 v119, v222, v218, s32
    v_mfma_f32_16x16x32_bf16 v[92:95], v[156:159], v[20:23], v[92:95]
    v_perm_b32 v123, v223, v219, s34
    v_perm_b32 v127, v223, v219, s32
    s_waitcnt vmcnt(6)
    v_perm_b32 v128, v228, v224, s34
    v_perm_b32 v132, v228, v224, s32
    v_mfma_f32_16x16x32_bf16 v[32:35], v[96:99], v[160:163], v[32:35]
    v_perm_b32 v136, v229, v225, s34
    v_perm_b32 v140, v229, v225, s32
    v_perm_b32 v144, v230, v226, s34
    v_mfma_f32_16x16x32_bf16 v[36:39], v[100:103], v[160:163], v[36:39]
    v_perm_b32 v148, v230, v226, s32
    v_perm_b32 v152, v231, v227, s34
    v_perm_b32 v156, v231, v227, s32
    v_mfma_f32_16x16x32_bf16 v[40:43], v[104:107], v[160:163], v[40:43]
    s_waitcnt vmcnt(4)
    v_perm_b32 v129, v236, v232, s34
    v_accvgpr_read_b32 v4, a128
    v_perm_b32 v133, v236, v232, s32
    v_mfma_f32_16x16x32_bf16 v[44:47], v[108:111], v[160:163], v[44:47]
    v_perm_b32 v137, v237, v233, s34
    v_and_b32 v3, 7, v0
    v_perm_b32 v141, v237, v233, s32
    v_lshlrev_b32 v3, 8, v3
    v_perm_b32 v145, v238, v234, s34
    v_mfma_f32_16x16x32_bf16 v[48:51], v[112:115], v[160:163], v[48:51]
    v_perm_b32 v149, v238, v234, s32
    v_add_f32_dpp v4, v4, v4 row_ror:8 row_mask:0xf bank_mask:0xf
    v_perm_b32 v153, v239, v235, s34
    v_lshrrev_b32 v1, 3, v0
    v_perm_b32 v157, v239, v235, s32
    v_mfma_f32_16x16x32_bf16 v[52:55], v[116:119], v[160:163], v[52:55]
    s_waitcnt vmcnt(2)
    v_perm_b32 v130, v244, v240, s34
    v_rcp_f32 v2, v4
    v_perm_b32 v134, v244, v240, s32
    v_mfma_f32_16x16x32_bf16 v[56:59], v[120:123], v[160:163], v[56:59]
    v_perm_b32 v138, v245, v241, s34
    v_lshl_add_u32 v3, v1, 5, v3
    v_perm_b32 v142, v245, v241, s32
    v_perm_b32 v146, v246, v242, s34
    v_mfma_f32_16x16x32_bf16 v[60:63], v[124:127], v[160:163], v[60:63]
    v_perm_b32 v150, v246, v242, s32
    v_perm_b32 v154, v247, v243, s34
    v_perm_b32 v158, v247, v243, s32
    s_waitcnt vmcnt(0)
    v_perm_b32 v131, v252, v248, s34
    v_perm_b32 v135, v252, v248, s32
    v_perm_b32 v139, v253, v249, s34
    v_mfma_f32_16x16x32_bf16 v[64:67], v[128:131], v[160:163], v[64:67]
    v_perm_b32 v143, v253, v249, s32
    v_mfma_f32_16x16x32_bf16 v[68:71], v[132:135], v[160:163], v[68:71]
    v_perm_b32 v147, v254, v250, s34
    v_mfma_f32_16x16x32_bf16 v[72:75], v[136:139], v[160:163], v[72:75]
    v_perm_b32 v151, v254, v250, s32
    v_mfma_f32_16x16x32_bf16 v[76:79], v[140:143], v[160:163], v[76:79]
    v_perm_b32 v155, v255, v251, s34
    v_mfma_f32_16x16x32_bf16 v[80:83], v[144:147], v[160:163], v[80:83]
    v_perm_b32 v159, v255, v251, s32
    v_mfma_f32_16x16x32_bf16 v[84:87], v[148:151], v[160:163], v[84:87]
    v_mfma_f32_16x16x32_bf16 v[88:91], v[152:155], v[160:163], v[88:91]
    v_mfma_f32_16x16x32_bf16 v[92:95], v[156:159], v[160:163], v[92:95]
    v_add_f32_dpp v96, v64, v32 row_ror:8 row_mask:0xf bank_mask:0x3
    v_add_f32_dpp v96, v34, v66 row_ror:8 row_mask:0xf bank_mask:0xc
    v_add_f32_dpp v97, v68, v36 row_ror:8 row_mask:0xf bank_mask:0x3
    v_add_f32_dpp v97, v38, v70 row_ror:8 row_mask:0xf bank_mask:0xc
    v_add_f32_dpp v98, v72, v40 row_ror:8 row_mask:0xf bank_mask:0x3
    v_add_f32_dpp v98, v42, v74 row_ror:8 row_mask:0xf bank_mask:0xc
    v_add_f32_dpp v99, v76, v44 row_ror:8 row_mask:0xf bank_mask:0x3
    v_add_f32_dpp v99, v46, v78 row_ror:8 row_mask:0xf bank_mask:0xc
    v_add_f32_dpp v100, v80, v48 row_ror:8 row_mask:0xf bank_mask:0x3
    v_add_f32_dpp v100, v50, v82 row_ror:8 row_mask:0xf bank_mask:0xc
    v_add_f32_dpp v101, v84, v52 row_ror:8 row_mask:0xf bank_mask:0x3
    v_add_f32_dpp v101, v54, v86 row_ror:8 row_mask:0xf bank_mask:0xc
    v_add_f32_dpp v102, v88, v56 row_ror:8 row_mask:0xf bank_mask:0x3
    v_add_f32_dpp v102, v58, v90 row_ror:8 row_mask:0xf bank_mask:0xc
    v_add_f32_dpp v103, v92, v60 row_ror:8 row_mask:0xf bank_mask:0x3
    v_add_f32_dpp v103, v62, v94 row_ror:8 row_mask:0xf bank_mask:0xc
    v_pk_mul_f32 v[96:97], v[96:97], v[2:3] op_sel_hi:[1,0]
    v_pk_mul_f32 v[98:99], v[98:99], v[2:3] op_sel_hi:[1,0]
    v_pk_mul_f32 v[100:101], v[100:101], v[2:3] op_sel_hi:[1,0]
    v_pk_mul_f32 v[102:103], v[102:103], v[2:3] op_sel_hi:[1,0]
    v_cvt_pk_bf16_f32 v24, v96, v97
    v_cvt_pk_bf16_f32 v25, v98, v99
    v_cvt_pk_bf16_f32 v26, v100, v101
    v_cvt_pk_bf16_f32 v27, v102, v103
    buffer_store_dwordx4 v[24:27], v3, s[28:31], 0 offen offset:0
    v_add_f32_dpp v104, v65, v33 row_ror:8 row_mask:0xf bank_mask:0x3
    v_add_f32_dpp v104, v35, v67 row_ror:8 row_mask:0xf bank_mask:0xc
    v_add_f32_dpp v105, v69, v37 row_ror:8 row_mask:0xf bank_mask:0x3
    v_add_f32_dpp v105, v39, v71 row_ror:8 row_mask:0xf bank_mask:0xc
    v_add_f32_dpp v106, v73, v41 row_ror:8 row_mask:0xf bank_mask:0x3
    v_add_f32_dpp v106, v43, v75 row_ror:8 row_mask:0xf bank_mask:0xc
    v_add_f32_dpp v107, v77, v45 row_ror:8 row_mask:0xf bank_mask:0x3
    v_add_f32_dpp v107, v47, v79 row_ror:8 row_mask:0xf bank_mask:0xc
    v_add_f32_dpp v108, v81, v49 row_ror:8 row_mask:0xf bank_mask:0x3
    v_add_f32_dpp v108, v51, v83 row_ror:8 row_mask:0xf bank_mask:0xc
    v_add_f32_dpp v109, v85, v53 row_ror:8 row_mask:0xf bank_mask:0x3
    v_add_f32_dpp v109, v55, v87 row_ror:8 row_mask:0xf bank_mask:0xc
    v_add_f32_dpp v110, v89, v57 row_ror:8 row_mask:0xf bank_mask:0x3
    v_add_f32_dpp v110, v59, v91 row_ror:8 row_mask:0xf bank_mask:0xc
    v_add_f32_dpp v111, v93, v61 row_ror:8 row_mask:0xf bank_mask:0x3
    v_add_f32_dpp v111, v63, v95 row_ror:8 row_mask:0xf bank_mask:0xc
    v_pk_mul_f32 v[104:105], v[104:105], v[2:3] op_sel_hi:[1,0]
    v_pk_mul_f32 v[106:107], v[106:107], v[2:3] op_sel_hi:[1,0]
    v_pk_mul_f32 v[108:109], v[108:109], v[2:3] op_sel_hi:[1,0]
    v_pk_mul_f32 v[110:111], v[110:111], v[2:3] op_sel_hi:[1,0]
    v_cvt_pk_bf16_f32 v28, v104, v105
    v_cvt_pk_bf16_f32 v29, v106, v107
    v_cvt_pk_bf16_f32 v30, v108, v109
    v_cvt_pk_bf16_f32 v31, v110, v111
    buffer_store_dwordx4 v[28:31], v3, s[28:31], 0 offen offset:16
L_end:
    s_endpgm
.section .rodata,"a"
.p2align 6
.amdhsa_kernel standalone__mha_softmax__sampling_kernel
  .amdhsa_next_free_vgpr 392
  .amdhsa_next_free_sgpr 76
  .amdhsa_accum_offset 256
  .amdhsa_group_segment_fixed_size 0
  .amdhsa_kernarg_size 48
  .amdhsa_user_sgpr_count 2
  .amdhsa_user_sgpr_kernarg_segment_ptr 1
  .amdhsa_system_sgpr_workgroup_id_x 1
.end_amdhsa_kernel
```
